```python
import torch

def _softmax(x, axis=-1):
    return torch.softmax(x, dim=axis)
def _gelu(x):
    return torch.nn.functional.gelu(x, approximate="tanh")
def _silu(x):
    return torch.nn.functional.silu(x)
def _sigmoid(x):
    return torch.sigmoid(x)
def _layernorm(x, axis=-1, eps=1e-5):
    m = x.mean(dim=axis, keepdim=True)
    v = x.var(dim=axis, keepdim=True, unbiased=False)
    return (x - m) / torch.sqrt(v + eps)
def _scatter_add(tgt, idx, src, axis=0):
    return tgt.clone().index_add_(axis, idx, src)
def _segment_sum(src, seg, n):
    out = torch.zeros((n,) + src.shape[1:], dtype=src.dtype)
    return out.index_add_(0, seg, src)
def _pad(x, pw):
    flat = tuple(v for pair in reversed(pw) for v in pair)
    return torch.nn.functional.pad(x, flat)

kernel_name = 'standalone__gqa_softmax__near_ridge'

def setup_inputs():

    _w = (lambda a: (lambda t: t.to(torch.bfloat16) if t.is_floating_point() else t)(torch.as_tensor(a)))
    B, Hq, Hkv, Sq, Sk, D = 8, 32, 4, 32, 2048, 128
    return {
        "q": _w((lambda *s: torch.randn(*s, dtype=torch.bfloat16) * 0.8)(B, Hq, Sq, D)),
        "k": _w((lambda *s: torch.randn(*s, dtype=torch.bfloat16) * 0.8)(B, Hkv, Sk, D)),
        "v": _w((lambda *s: torch.randn(*s, dtype=torch.bfloat16) * 0.05)(B, Hkv, Sk, D)),
    }

def reference(q, k, v):
    B, Hq, Sq, D = q.shape
    Hkv = k.shape[1]
    rep = Hq // Hkv
    k = (lambda x, n, axis: torch.repeat_interleave(x, n, dim=axis))(k, rep, axis=1)
    v = (lambda x, n, axis: torch.repeat_interleave(x, n, dim=axis))(v, rep, axis=1)
    scale = D ** -0.5
    scores = torch.einsum("bhqd,bhkd->bhqk", q, k) * scale
    p = _softmax(scores, axis=-1)
    return torch.einsum("bhqk,bhkd->bhqd", p, v)
```

```asm
; @launch grid=(256,1,1) block=(768,1,1) lds=147712
.amdgcn_target "amdgcn-amd-amdhsa--gfx950"
.text
.globl standalone__gqa_softmax__near_ridge_kernel
.p2align 8
.type standalone__gqa_softmax__near_ridge_kernel,@function
standalone__gqa_softmax__near_ridge_kernel:
  s_cmp_ge_u32 s2, 256
  s_cbranch_scc1 L_done
  s_load_dwordx8 s[4:11], s[0:1], 0
  s_load_dwordx4 s[12:15], s[0:1], 32
  v_lshrrev_b32 v73, 6, v0
  v_and_b32 v72, 63, v0
  v_readfirstlane_b32 s36, v73
  s_and_b32 s37, s2, 7
  s_lshr_b32 s62, s2, 3
  s_lshl_b32 s37, s37, 2
  s_lshr_b32 s39, s62, 3
  s_add_u32 s37, s37, s39
  s_and_b32 s62, s62, 7
  s_lshr_b32 s39, s62, 2
  s_and_b32 s38, s62, 3
  s_lshl_b32 s42, s37, 16
  s_lshl_b32 s43, s39, 15
  s_add_u32 s42, s42, s43
  s_getreg_b32 s48, hwreg(HW_REG_XCC_ID, 0, 4)
  s_lshl_b32 s48, s48, 2
  s_mov_b32 s96, 0x200000
  s_cmp_ge_u32 s36, 4
  s_cbranch_scc1 L_compute
  s_setprio 3
  v_lshrrev_b32 v73, 4, v72
  v_and_b32 v74, 15, v72
  v_xor_b32 v75, v74, v73
  v_lshlrev_b32 v75, 4, v75
  v_lshl_add_u32 v1, v73, 8, v75
  s_lshl_b32 s43, s37, 19
  s_lshl_b32 s45, s38, 17
  s_add_u32 s43, s43, s45
  s_and_b32 s40, s36, 3
  s_lshl_b32 s41, s40, 12
  s_mul_i32 s46, s40, 4352
  s_lshr_b32 s47, s40, 1
  s_mul_i32 s47, s47, 8704
  s_and_b32 s49, s40, 1
  s_lshl_b32 s49, s49, 12
  s_add_u32 s47, s47, s49
  s_mov_b32 s18, 32768
  s_mov_b32 s19, 0x20000
  s_mov_b32 s22, 131072
  s_mov_b32 s23, 0x20000
  s_waitcnt lgkmcnt(0)
  s_add_u32 s20, s6, s43
  s_addc_u32 s21, s7, 0
  s_add_u32 s16, s4, s42
  s_addc_u32 s17, s5, 0
  s_add_u32 m0, s46, 0
  s_add_u32 s59, s41, 0
  buffer_load_dwordx4 v1, s[20:23], s59 offen nt lds
  s_add_u32 m0, s46, 1088
  s_add_u32 s59, s41, 1024
  buffer_load_dwordx4 v1, s[20:23], s59 offen nt lds
  s_add_u32 m0, s46, 2176
  s_add_u32 s59, s41, 2048
  buffer_load_dwordx4 v1, s[20:23], s59 offen nt lds
  s_add_u32 m0, s46, 3264
  s_add_u32 s59, s41, 3072
  buffer_load_dwordx4 v1, s[20:23], s59 offen nt lds
  s_add_u32 m0, s46, 52224
  s_add_u32 s59, s41, 0
  buffer_load_dwordx4 v1, s[16:19], s59 offen lds
  s_add_u32 m0, s46, 53312
  s_add_u32 s59, s41, 1024
  buffer_load_dwordx4 v1, s[16:19], s59 offen lds
  s_add_u32 m0, s46, 54400
  s_add_u32 s59, s41, 2048
  buffer_load_dwordx4 v1, s[16:19], s59 offen lds
  s_add_u32 m0, s46, 55488
  s_add_u32 s59, s41, 3072
  buffer_load_dwordx4 v1, s[16:19], s59 offen lds
  s_add_u32 m0, s46, 121856
  s_add_u32 s59, s41, 16384
  buffer_load_dwordx4 v1, s[16:19], s59 offen lds
  s_add_u32 m0, s46, 122944
  s_add_u32 s59, s41, 17408
  buffer_load_dwordx4 v1, s[16:19], s59 offen lds
  s_add_u32 m0, s46, 124032
  s_add_u32 s59, s41, 18432
  buffer_load_dwordx4 v1, s[16:19], s59 offen lds
  s_add_u32 m0, s46, 125120
  s_add_u32 s59, s41, 19456
  buffer_load_dwordx4 v1, s[16:19], s59 offen lds
  s_add_u32 m0, s46, 69632
  s_add_u32 s59, s41, 16384
  buffer_load_dwordx4 v1, s[20:23], s59 offen nt lds
  s_add_u32 m0, s46, 70720
  s_add_u32 s59, s41, 17408
  buffer_load_dwordx4 v1, s[20:23], s59 offen nt lds
  s_add_u32 m0, s46, 71808
  s_add_u32 s59, s41, 18432
  buffer_load_dwordx4 v1, s[20:23], s59 offen nt lds
  s_add_u32 m0, s46, 72896
  s_add_u32 s59, s41, 19456
  buffer_load_dwordx4 v1, s[20:23], s59 offen nt lds
  v_mov_b32 v4, 1
  v_lshlrev_b32 v75, 2, v73
  v_xor_b32 v75, v74, v75
  v_lshlrev_b32 v75, 4, v75
  v_lshl_add_u32 v2, v73, 8, v75
  s_mov_b32 s26, 131072
  s_mov_b32 s27, 0x20000
  s_add_u32 s24, s8, s43
  s_addc_u32 s25, s9, 0
  s_lshl_b32 s50, s37, 3
  v_mov_b32 v7, s50
  s_lshl_b32 s50, s37, 18
  s_add_u32 s32, s14, s50
  s_addc_u32 s33, s15, 0
  s_mov_b32 s34, 262144
  s_mov_b32 s35, 0x20000
  v_lshlrev_b32 v6, 4, v72
  v_mov_b32 v12, -1
  v_mov_b32 v13, -1
  v_mov_b32 v14, -1
  v_mov_b32 v15, -1
  s_lshl_b32 s80, s62, 15
  s_lshl_b32 s50, s40, 13
  s_add_u32 s80, s80, s50
  s_lshl_b32 s51, 1, s48
  s_lshl_b32 s48, 8, s48
  v_mov_b32 v8, s51
  s_add_u32 s86, s47, 17408
  s_add_u32 s87, s41, 0
  s_mov_b32 m0, s86
  s_nop 0
  buffer_load_dwordx4 v2, s[24:27], s87 offen offset:0 nt lds
  buffer_load_dwordx4 v2, s[24:27], s87 offen offset:1024 nt lds
  buffer_load_dwordx4 v2, s[24:27], s87 offen offset:2048 nt lds
  buffer_load_dwordx4 v2, s[24:27], s87 offen offset:3072 nt lds
  s_waitcnt vmcnt(8)
  s_barrier
  s_add_u32 m0, s46, 87040
  s_add_u32 s59, s41, 32768
  buffer_load_dwordx4 v1, s[20:23], s59 offen nt lds
  s_add_u32 m0, s46, 88128
  s_add_u32 s59, s41, 33792
  buffer_load_dwordx4 v1, s[20:23], s59 offen nt lds
  s_add_u32 m0, s46, 89216
  s_add_u32 s59, s41, 34816
  buffer_load_dwordx4 v1, s[20:23], s59 offen nt lds
  s_add_u32 m0, s46, 90304
  s_add_u32 s59, s41, 35840
  buffer_load_dwordx4 v1, s[20:23], s59 offen nt lds
  s_add_u32 s86, s47, 34816
  s_add_u32 s87, s41, 16384
  s_mov_b32 m0, s86
  s_nop 0
  buffer_load_dwordx4 v2, s[24:27], s87 offen offset:0 nt lds
  buffer_load_dwordx4 v2, s[24:27], s87 offen offset:1024 nt lds
  buffer_load_dwordx4 v2, s[24:27], s87 offen offset:2048 nt lds
  buffer_load_dwordx4 v2, s[24:27], s87 offen offset:3072 nt lds
  s_waitcnt vmcnt(8)
  s_barrier
  s_add_u32 m0, s46, 104448
  s_add_u32 s59, s41, 49152
  buffer_load_dwordx4 v1, s[20:23], s59 offen nt lds
  s_add_u32 m0, s46, 105536
  s_add_u32 s59, s41, 50176
  buffer_load_dwordx4 v1, s[20:23], s59 offen nt lds
  s_add_u32 m0, s46, 106624
  s_add_u32 s59, s41, 51200
  buffer_load_dwordx4 v1, s[20:23], s59 offen nt lds
  s_add_u32 m0, s46, 107712
  s_add_u32 s59, s41, 52224
  buffer_load_dwordx4 v1, s[20:23], s59 offen nt lds
  s_cmp_lg_u32 s40, 0
  s_cbranch_scc1 L_noann
  s_mov_b64 exec, 1
  global_atomic_add v7, v8, s[12:13]
  s_mov_b64 exec, -1
L_noann:
  s_add_u32 s86, s47, 52224
  s_add_u32 s87, s41, 32768
  s_mov_b32 m0, s86
  s_nop 0
  buffer_load_dwordx4 v2, s[24:27], s87 offen offset:0 nt lds
  buffer_load_dwordx4 v2, s[24:27], s87 offen offset:1024 nt lds
  buffer_load_dwordx4 v2, s[24:27], s87 offen offset:2048 nt lds
  buffer_load_dwordx4 v2, s[24:27], s87 offen offset:3072 nt lds
  s_add_u32 m0, s46, 121856
  s_add_u32 s59, s41, 65536
  buffer_load_dwordx4 v1, s[20:23], s59 offen nt lds
  s_add_u32 m0, s46, 122944
  s_add_u32 s59, s41, 66560
  buffer_load_dwordx4 v1, s[20:23], s59 offen nt lds
  s_add_u32 m0, s46, 124032
  s_add_u32 s59, s41, 67584
  buffer_load_dwordx4 v1, s[20:23], s59 offen nt lds
  s_add_u32 m0, s46, 125120
  s_add_u32 s59, s41, 68608
  buffer_load_dwordx4 v1, s[20:23], s59 offen nt lds
  s_waitcnt vmcnt(12)
  s_barrier
  s_add_u32 s86, s47, 0
  s_add_u32 s87, s41, 49152
  s_mov_b32 m0, s86
  s_nop 0
  buffer_load_dwordx4 v2, s[24:27], s87 offen offset:0 nt lds
  buffer_load_dwordx4 v2, s[24:27], s87 offen offset:1024 nt lds
  buffer_load_dwordx4 v2, s[24:27], s87 offen offset:2048 nt lds
  buffer_load_dwordx4 v2, s[24:27], s87 offen offset:3072 nt lds
  s_add_u32 m0, s46, 69632
  s_add_u32 s59, s41, 81920
  buffer_load_dwordx4 v1, s[20:23], s59 offen nt lds
  s_add_u32 m0, s46, 70720
  s_add_u32 s59, s41, 82944
  buffer_load_dwordx4 v1, s[20:23], s59 offen nt lds
  s_add_u32 m0, s46, 71808
  s_add_u32 s59, s41, 83968
  buffer_load_dwordx4 v1, s[20:23], s59 offen nt lds
  s_add_u32 m0, s46, 72896
  s_add_u32 s59, s41, 84992
  buffer_load_dwordx4 v1, s[20:23], s59 offen nt lds
  s_waitcnt vmcnt(12)
  s_barrier
  s_add_u32 s86, s47, 17408
  s_add_u32 s87, s41, 65536
  s_mov_b32 m0, s86
  s_nop 0
  buffer_load_dwordx4 v2, s[24:27], s87 offen offset:0 nt lds
  buffer_load_dwordx4 v2, s[24:27], s87 offen offset:1024 nt lds
  buffer_load_dwordx4 v2, s[24:27], s87 offen offset:2048 nt lds
  buffer_load_dwordx4 v2, s[24:27], s87 offen offset:3072 nt lds
  s_add_u32 m0, s46, 87040
  s_add_u32 s59, s41, 98304
  buffer_load_dwordx4 v1, s[20:23], s59 offen nt lds
  s_add_u32 m0, s46, 88128
  s_add_u32 s59, s41, 99328
  buffer_load_dwordx4 v1, s[20:23], s59 offen nt lds
  s_add_u32 m0, s46, 89216
  s_add_u32 s59, s41, 100352
  buffer_load_dwordx4 v1, s[20:23], s59 offen nt lds
  s_add_u32 m0, s46, 90304
  s_add_u32 s59, s41, 101376
  buffer_load_dwordx4 v1, s[20:23], s59 offen nt lds
  global_load_dwordx2 v[8:9], v7, s[12:13] sc1
  s_waitcnt vmcnt(13)
  s_barrier
  s_add_u32 s86, s47, 34816
  s_add_u32 s87, s41, 81920
  s_mov_b32 m0, s86
  s_nop 0
  buffer_load_dwordx4 v2, s[24:27], s87 offen offset:0 nt lds
  buffer_load_dwordx4 v2, s[24:27], s87 offen offset:1024 nt lds
  buffer_load_dwordx4 v2, s[24:27], s87 offen offset:2048 nt lds
  buffer_load_dwordx4 v2, s[24:27], s87 offen offset:3072 nt lds
  s_add_u32 m0, s46, 104448
  s_add_u32 s59, s41, 114688
  buffer_load_dwordx4 v1, s[20:23], s59 offen nt lds
  s_add_u32 m0, s46, 105536
  s_add_u32 s59, s41, 115712
  buffer_load_dwordx4 v1, s[20:23], s59 offen nt lds
  s_add_u32 m0, s46, 106624
  s_add_u32 s59, s41, 116736
  buffer_load_dwordx4 v1, s[20:23], s59 offen nt lds
  s_add_u32 m0, s46, 107712
  s_add_u32 s59, s41, 117760
  buffer_load_dwordx4 v1, s[20:23], s59 offen nt lds
  s_waitcnt vmcnt(8)
  v_readfirstlane_b32 s50, v8
  s_cmp_eq_u32 s50, s48
  s_cbranch_scc0 L_clr_slow
  s_add_u32 s63, s80, 0
  buffer_store_dwordx4 v[12:15], v6, s[32:35], s63 offen offset:0
  buffer_store_dwordx4 v[12:15], v6, s[32:35], s63 offen offset:1024
  buffer_store_dwordx4 v[12:15], v6, s[32:35], s63 offen offset:2048
  s_mov_b64 exec, 0xffff
  buffer_store_dwordx4 v[12:15], v6, s[32:35], s63 offen offset:3072
  s_mov_b64 exec, -1
  s_add_u32 s63, s80, 4096
  buffer_store_dwordx4 v[12:15], v6, s[32:35], s63 offen offset:0
  buffer_store_dwordx4 v[12:15], v6, s[32:35], s63 offen offset:1024
  buffer_store_dwordx4 v[12:15], v6, s[32:35], s63 offen offset:2048
  s_mov_b64 exec, 0xffff
  buffer_store_dwordx4 v[12:15], v6, s[32:35], s63 offen offset:3072
  s_mov_b64 exec, -1
  s_branch L_clr_done
L_clr_slow:
  s_add_u32 s63, s80, 0
  buffer_store_dwordx4 v[12:15], v6, s[32:35], s63 offen offset:0 sc1
  buffer_store_dwordx4 v[12:15], v6, s[32:35], s63 offen offset:1024 sc1
  buffer_store_dwordx4 v[12:15], v6, s[32:35], s63 offen offset:2048 sc1
  s_mov_b64 exec, 0xffff
  buffer_store_dwordx4 v[12:15], v6, s[32:35], s63 offen offset:3072 sc1
  s_mov_b64 exec, -1
  s_add_u32 s63, s80, 4096
  buffer_store_dwordx4 v[12:15], v6, s[32:35], s63 offen offset:0 sc1
  buffer_store_dwordx4 v[12:15], v6, s[32:35], s63 offen offset:1024 sc1
  buffer_store_dwordx4 v[12:15], v6, s[32:35], s63 offen offset:2048 sc1
  s_mov_b64 exec, 0xffff
  buffer_store_dwordx4 v[12:15], v6, s[32:35], s63 offen offset:3072 sc1
  s_mov_b64 exec, -1
L_clr_done:
  s_barrier
  s_add_u32 s86, s47, 52224
  s_add_u32 s87, s41, 98304
  s_mov_b32 m0, s86
  s_nop 0
  buffer_load_dwordx4 v2, s[24:27], s87 offen offset:0 nt lds
  buffer_load_dwordx4 v2, s[24:27], s87 offen offset:1024 nt lds
  buffer_load_dwordx4 v2, s[24:27], s87 offen offset:2048 nt lds
  buffer_load_dwordx4 v2, s[24:27], s87 offen offset:3072 nt lds
  s_add_u32 s86, s47, 121856
  s_add_u32 s87, s41, 114688
  s_mov_b32 m0, s86
  s_nop 0
  buffer_load_dwordx4 v2, s[24:27], s87 offen offset:0 nt lds
  buffer_load_dwordx4 v2, s[24:27], s87 offen offset:1024 nt lds
  buffer_load_dwordx4 v2, s[24:27], s87 offen offset:2048 nt lds
  buffer_load_dwordx4 v2, s[24:27], s87 offen offset:3072 nt lds
  s_waitcnt vmcnt(20)
  s_waitcnt vmcnt(8)
  s_barrier
  s_cmp_lg_u32 s40, 0
  s_cbranch_scc1 L_noann2
  s_mov_b64 exec, 1
  global_atomic_add v7, v4, s[12:13] offset:4
  s_mov_b64 exec, -1
L_noann2:
  s_waitcnt vmcnt(4)
  s_waitcnt vmcnt(0)
  s_barrier
  s_add_u32 s63, s80, 0
  buffer_load_dwordx4 v[16:19], v6, s[32:35], s63 offen offset:0 sc1
  buffer_load_dwordx4 v[16:19], v6, s[32:35], s63 offen offset:1024 sc1
  buffer_load_dwordx4 v[16:19], v6, s[32:35], s63 offen offset:2048 sc1
  s_mov_b64 exec, 0xffff
  buffer_load_dwordx4 v[16:19], v6, s[32:35], s63 offen offset:3072 sc1
  s_mov_b64 exec, -1
  s_add_u32 s63, s80, 4096
  buffer_load_dwordx4 v[16:19], v6, s[32:35], s63 offen offset:0 sc1
  buffer_load_dwordx4 v[16:19], v6, s[32:35], s63 offen offset:1024 sc1
  buffer_load_dwordx4 v[16:19], v6, s[32:35], s63 offen offset:2048 sc1
  s_mov_b64 exec, 0xffff
  buffer_load_dwordx4 v[16:19], v6, s[32:35], s63 offen offset:3072 sc1
  s_mov_b64 exec, -1
  s_barrier
  s_barrier
  s_endpgm
L_compute:
  s_sub_u32 s36, s36, 4
  s_and_b32 s40, s36, 3
  s_lshr_b32 s41, s36, 2
  s_lshl_b32 s48, 8, s48
  s_mov_b32 s44, 0x3e0293ee
  s_mov_b32 s60, 0x44800000
  s_mov_b32 s61, 0
  v_and_b32 v73, 3, v72
  v_bfe_u32 v74, v72, 2, 3
  v_lshrrev_b32 v75, 5, v72
  v_mul_u32_u24 v74, 1088, v74
  v_lshl_add_u32 v74, v73, 8, v74
  v_xor_b32 v76, v75, v73
  v_lshl_add_u32 v74, v76, 4, v74
  s_mul_i32 s45, s41, 8704
  s_add_u32 s46, s45, 69632
  v_add_u32 v156, s46, v74
  v_add_u32 v32, s45, v74
  s_lshr_b32 s50, s40, 1
  s_mul_i32 s49, s50, 69632
  s_and_b32 s50, s40, 1
  s_mul_i32 s50, s50, 8704
  s_add_u32 s49, s49, s50
  s_add_u32 s49, s49, 52224
  v_add_u32 v34, s49, v74
  v_xor_b32 v157, 32, v156
  v_xor_b32 v33, 32, v32
  v_xor_b32 v35, 32, v34
  s_lshl_b32 s50, s41, 7
  s_lshl_b32 s51, s38, 5
  s_or_b32 s50, s50, s51
  v_bfe_u32 v73, v72, 2, 2
  v_and_b32 v74, 3, v72
  v_bfe_u32 v76, v72, 4, 1
  v_lshl_add_u32 v162, v75, 2, v73
  v_lshlrev_b32 v162, 8, v162
  v_lshl_add_u32 v162, v73, 6, v162
  v_lshl_add_u32 v162, v76, 5, v162
  v_lshl_add_u32 v162, v74, 3, v162
  v_xor_b32 v162, s50, v162
  s_add_u32 s47, s45, 17408
  v_add_u32 v158, s47, v162
  v_xor_b32 v159, 64, v158
  v_xor_b32 v160, 0x80, v158
  v_xor_b32 v161, 0xc0, v158
  s_lshl_b32 s80, s62, 3
  s_add_u32 s80, s80, s36
  s_lshl_b32 s80, s80, 12
  s_xor_b32 s85, s36, 4
  s_waitcnt lgkmcnt(0)
  s_add_u32 s28, s10, s42
  s_addc_u32 s29, s11, 0
  s_mov_b32 s30, 32768
  s_mov_b32 s31, 0x20000
  s_lshl_b32 s50, s37, 18
  s_add_u32 s32, s14, s50
  s_addc_u32 s33, s15, 0
  s_mov_b32 s34, 262144
  s_mov_b32 s35, 0x20000
  v_mov_b32 v36, 0
  v_mov_b32 v37, 0
  v_mov_b32 v38, 0
  v_mov_b32 v39, 0
  v_mov_b32 v40, 0
  v_mov_b32 v41, 0
  v_mov_b32 v42, 0
  v_mov_b32 v43, 0
  v_mov_b32 v44, 0
  v_mov_b32 v45, 0
  v_mov_b32 v46, 0
  v_mov_b32 v47, 0
  v_mov_b32 v48, 0
  v_mov_b32 v49, 0
  v_mov_b32 v50, 0
  v_mov_b32 v51, 0
  v_mov_b32 v52, 0
  v_mov_b32 v53, 0
  v_mov_b32 v54, 0
  v_mov_b32 v55, 0
  v_mov_b32 v56, 0
  v_mov_b32 v57, 0
  v_mov_b32 v58, 0
  v_mov_b32 v59, 0
  v_mov_b32 v60, 0
  v_mov_b32 v61, 0
  v_mov_b32 v62, 0
  v_mov_b32 v63, 0
  v_mov_b32 v64, 0
  v_mov_b32 v65, 0
  v_mov_b32 v66, 0
  v_mov_b32 v67, 0
  v_mov_b32 v68, 0
  v_mov_b32 v69, 0
  v_mov_b32 v70, 0
  v_mov_b32 v71, 0
  v_mov_b32 v72, 0
  v_mov_b32 v73, 0
  v_mov_b32 v74, 0
  v_mov_b32 v75, 0
  v_mov_b32 v76, 0
  v_mov_b32 v77, 0
  v_mov_b32 v78, 0
  v_mov_b32 v79, 0
  v_mov_b32 v80, 0
  v_mov_b32 v81, 0
  v_mov_b32 v82, 0
  v_mov_b32 v83, 0
  v_mov_b32 v84, 0
  v_mov_b32 v85, 0
  v_mov_b32 v86, 0
  v_mov_b32 v87, 0
  v_mov_b32 v88, 0
  v_mov_b32 v89, 0
  v_mov_b32 v90, 0
  v_mov_b32 v91, 0
  v_mov_b32 v92, 0
  v_mov_b32 v93, 0
  v_mov_b32 v94, 0
  v_mov_b32 v95, 0
  s_barrier
  ds_read_b128 v[0:3], v34 offset:0
  ds_read_b128 v[4:7], v35 offset:0
  ds_read_b128 v[8:11], v34 offset:64
  ds_read_b128 v[12:15], v35 offset:64
  ds_read_b128 v[16:19], v34 offset:128
  ds_read_b128 v[20:23], v35 offset:128
  ds_read_b128 v[24:27], v34 offset:192
  ds_read_b128 v[28:31], v35 offset:192
  ds_read_b128 v[136:139], v32 offset:0
  ds_read_b128 v[140:143], v33 offset:0
  ds_read_b128 v[144:147], v32 offset:64
  s_waitcnt lgkmcnt(3)
  ds_read_b128 v[148:151], v33 offset:64
  s_waitcnt lgkmcnt(3)
  v_mfma_f32_32x32x16_bf16 v[96:111], v[136:139], v[0:3], 0
  ds_read_b128 v[136:139], v32 offset:128
  s_waitcnt lgkmcnt(3)
  v_mfma_f32_32x32x16_bf16 v[96:111], v[140:143], v[4:7], v[96:111]
  ds_read_b128 v[140:143], v33 offset:128
  s_waitcnt lgkmcnt(3)
  v_mfma_f32_32x32x16_bf16 v[96:111], v[144:147], v[8:11], v[96:111]
  ds_read_b128 v[144:147], v32 offset:192
  s_waitcnt lgkmcnt(3)
  v_mfma_f32_32x32x16_bf16 v[96:111], v[148:151], v[12:15], v[96:111]
  ds_read_b128 v[148:151], v33 offset:192
  s_waitcnt lgkmcnt(3)
  v_mfma_f32_32x32x16_bf16 v[96:111], v[136:139], v[16:19], v[96:111]
  s_barrier
  ds_read_b128 v[136:139], v156 offset:0
  s_waitcnt lgkmcnt(3)
  v_mfma_f32_32x32x16_bf16 v[96:111], v[140:143], v[20:23], v[96:111]
  ds_read_b128 v[140:143], v157 offset:0
  s_waitcnt lgkmcnt(3)
  v_mfma_f32_32x32x16_bf16 v[96:111], v[144:147], v[24:27], v[96:111]
  ds_read_b128 v[144:147], v156 offset:64
  s_waitcnt lgkmcnt(3)
  v_mfma_f32_32x32x16_bf16 v[96:111], v[148:151], v[28:31], v[96:111]
  v_mov_b32 v32, 0
  v_mov_b32 v33, 0
  v_mov_b32 v34, 0
  v_mov_b32 v35, 0
  v_mov_b32 v163, 0
  s_mov_b32 s81, 0
  s_mov_b32 s84, 4294915072
  s_mov_b32 s86, 17408
  s_nop 3
  v_max3_f32 v152, v96, v97, v98
  v_max3_f32 v153, v99, v100, v101
  v_max3_f32 v152, v152, v102, v103
  v_max3_f32 v153, v153, v104, v105
  v_max3_f32 v152, v152, v106, v107
  v_max3_f32 v153, v153, v108, v109
  v_max3_f32 v152, v152, v110, v111
  v_max_f32 v152, v152, v153
  v_mov_b32 v153, v152
  s_nop 1
  v_permlane32_swap_b32 v152, v153
  v_max_f32 v152, v152, v153
  v_mul_f32 v162, s44, v152
  v_fma_f32 v112, v96, s44, -v162
  v_fma_f32 v113, v97, s44, -v162
  v_fma_f32 v114, v98, s44, -v162
  v_fma_f32 v115, v99, s44, -v162
  v_exp_f32 v152, v112
  v_exp_f32 v153, v113
  v_fma_f32 v116, v100, s44, -v162
  v_fma_f32 v117, v101, s44, -v162
  v_fma_f32 v118, v102, s44, -v162
  v_fma_f32 v119, v103, s44, -v162
  v_exp_f32 v154, v114
  v_exp_f32 v155, v115
  v_fma_f32 v120, v104, s44, -v162
  v_fma_f32 v121, v105, s44, -v162
  v_fma_f32 v122, v106, s44, -v162
  v_fma_f32 v123, v107, s44, -v162
  v_add_f32 v164, v152, v153
  v_cvt_pk_bf16_f32 v128, v152, v153
  v_fma_f32 v124, v108, s44, -v162
  v_fma_f32 v125, v109, s44, -v162
  v_fma_f32 v126, v110, s44, -v162
  v_fma_f32 v127, v111, s44, -v162
  s_nop 1
  s_branch L_loop_qk
.p2align 6
L_loop:
  ds_read_b64_tr_b16 v[148:149], v161 offset:0
  ds_read_b64_tr_b16 v[150:151], v161 offset:2048
  s_waitcnt lgkmcnt(6)
  v_mfma_f32_32x32x16_bf16 v[32:47], v[136:139], v[128:131], v[32:47]
  v_exp_f32 v155, v127
  v_add_f32 v164, v164, v152
  v_add_f32 v164, v164, v153
  v_cvt_pk_bf16_f32 v134, v152, v153
  ds_read_b64_tr_b16 v[136:137], v158 offset:4096
  ds_read_b64_tr_b16 v[138:139], v158 offset:6144
  s_waitcnt lgkmcnt(6)
  v_mfma_f32_32x32x16_bf16 v[48:63], v[140:143], v[128:131], v[48:63]
  v_add_f32 v164, v164, v154
  v_add_f32 v164, v164, v155
  v_cvt_pk_bf16_f32 v135, v154, v155
  v_cmp_lt_f32 vcc, s60, v164
  s_cbranch_vccnz L_rareC2l
L_backC2l:
  v_add_f32 v163, v163, v164
  ds_read_b64_tr_b16 v[140:141], v159 offset:4096
  ds_read_b64_tr_b16 v[142:143], v159 offset:6144
  s_waitcnt lgkmcnt(6)
  v_mfma_f32_32x32x16_bf16 v[64:79], v[144:147], v[128:131], v[64:79]
  v_fma_f32 v112, v96, s44, -v162
  v_fma_f32 v113, v97, s44, -v162
  v_fma_f32 v114, v98, s44, -v162
  v_fma_f32 v115, v99, s44, -v162
  v_exp_f32 v152, v112
  ds_read_b64_tr_b16 v[144:145], v160 offset:4096
  ds_read_b64_tr_b16 v[146:147], v160 offset:6144
  s_waitcnt lgkmcnt(6)
  v_mfma_f32_32x32x16_bf16 v[80:95], v[148:151], v[128:131], v[80:95]
  v_exp_f32 v153, v113
  v_fma_f32 v116, v100, s44, -v162
  v_fma_f32 v117, v101, s44, -v162
  ds_read_b64_tr_b16 v[148:149], v161 offset:4096
  ds_read_b64_tr_b16 v[150:151], v161 offset:6144
  s_waitcnt lgkmcnt(6)
  v_mfma_f32_32x32x16_bf16 v[32:47], v[136:139], v[132:135], v[32:47]
  s_and_b32 s50, s81, 3
  s_cmp_eq_u32 s50, 3
  s_cselect_b32 s86, s84, 17408
  v_fma_f32 v118, v102, s44, -v162
  v_fma_f32 v119, v103, s44, -v162
  v_exp_f32 v154, v114
  v_exp_f32 v155, v115
  s_barrier
  ds_read_b128 v[136:139], v156 offset:0
  s_waitcnt lgkmcnt(5)
  v_mfma_f32_32x32x16_bf16 v[48:63], v[140:143], v[132:135], v[48:63]
  v_add_u32 v158, s86, v158
  v_add_u32 v159, s86, v159
  v_fma_f32 v120, v104, s44, -v162
  v_fma_f32 v121, v105, s44, -v162
  ds_read_b128 v[140:143], v157 offset:0
  s_waitcnt lgkmcnt(4)
  v_mfma_f32_32x32x16_bf16 v[64:79], v[144:147], v[132:135], v[64:79]
  v_add_u32 v160, s86, v160
  v_add_u32 v161, s86, v161
  v_fma_f32 v122, v106, s44, -v162
  v_fma_f32 v123, v107, s44, -v162
  v_add_f32 v164, v152, v153
  ds_read_b128 v[144:147], v156 offset:64
  s_waitcnt lgkmcnt(3)
  v_mfma_f32_32x32x16_bf16 v[80:95], v[148:151], v[132:135], v[80:95]
  v_cvt_pk_bf16_f32 v128, v152, v153
  v_fma_f32 v124, v108, s44, -v162
  v_fma_f32 v125, v109, s44, -v162
  v_fma_f32 v126, v110, s44, -v162
  v_fma_f32 v127, v111, s44, -v162
L_loop_qk:
  ds_read_b128 v[148:151], v157 offset:64
  s_waitcnt lgkmcnt(3)
  v_mfma_f32_32x32x16_bf16 v[96:111], v[136:139], v[0:3], 0
  v_exp_f32 v152, v116
  v_exp_f32 v153, v117
  v_add_f32 v164, v164, v154
  ds_read_b128 v[136:139], v156 offset:128
  s_waitcnt lgkmcnt(3)
  v_mfma_f32_32x32x16_bf16 v[96:111], v[140:143], v[4:7], v[96:111]
  v_add_f32 v164, v164, v155
  v_cvt_pk_bf16_f32 v129, v154, v155
  v_exp_f32 v154, v118
  v_exp_f32 v155, v119
  ds_read_b128 v[140:143], v157 offset:128
  s_waitcnt lgkmcnt(3)
  v_mfma_f32_32x32x16_bf16 v[96:111], v[144:147], v[8:11], v[96:111]
  v_add_f32 v164, v164, v152
  v_add_f32 v164, v164, v153
  v_cvt_pk_bf16_f32 v130, v152, v153
  v_exp_f32 v152, v120
  ds_read_b128 v[144:147], v156 offset:192
  s_waitcnt lgkmcnt(3)
  v_mfma_f32_32x32x16_bf16 v[96:111], v[148:151], v[12:15], v[96:111]
  v_exp_f32 v153, v121
  v_add_f32 v164, v164, v154
  v_add_f32 v164, v164, v155
  v_cvt_pk_bf16_f32 v131, v154, v155
  ds_read_b128 v[148:151], v157 offset:192
  s_waitcnt lgkmcnt(3)
  v_mfma_f32_32x32x16_bf16 v[96:111], v[136:139], v[16:19], v[96:111]
  v_cmp_lt_f32 vcc, s60, v164
  s_cbranch_vccnz L_rareC1l
L_backC1l:
  v_add_f32 v163, v163, v164
  v_exp_f32 v154, v122
  v_add_u32 v156, s86, v156
  v_add_u32 v157, s86, v157
  ds_read_b64_tr_b16 v[136:137], v158 offset:0
  ds_read_b64_tr_b16 v[138:139], v158 offset:2048
  s_waitcnt lgkmcnt(4)
  v_mfma_f32_32x32x16_bf16 v[96:111], v[140:143], v[20:23], v[96:111]
  v_exp_f32 v155, v123
  v_add_f32 v164, v152, v153
  ds_read_b64_tr_b16 v[140:141], v159 offset:0
  ds_read_b64_tr_b16 v[142:143], v159 offset:2048
  s_waitcnt lgkmcnt(5)
  v_mfma_f32_32x32x16_bf16 v[96:111], v[144:147], v[24:27], v[96:111]
  v_cvt_pk_bf16_f32 v132, v152, v153
  v_exp_f32 v152, v124
  v_exp_f32 v153, v125
  ds_read_b64_tr_b16 v[144:145], v160 offset:0
  ds_read_b64_tr_b16 v[146:147], v160 offset:2048
  s_waitcnt lgkmcnt(6)
  v_mfma_f32_32x32x16_bf16 v[96:111], v[148:151], v[28:31], v[96:111]
  v_add_f32 v164, v164, v154
  v_add_f32 v164, v164, v155
  v_cvt_pk_bf16_f32 v133, v154, v155
  v_exp_f32 v154, v126
  s_add_u32 s81, s81, 1
  s_cmp_lt_u32 s81, 7
  s_nop 5
  s_cbranch_scc1 L_loop
  ds_read_b64_tr_b16 v[148:149], v161 offset:0
  ds_read_b64_tr_b16 v[150:151], v161 offset:2048
  s_waitcnt lgkmcnt(6)
  v_mfma_f32_32x32x16_bf16 v[32:47], v[136:139], v[128:131], v[32:47]
  v_exp_f32 v155, v127
  v_add_f32 v164, v164, v152
  v_add_f32 v164, v164, v153
  v_cvt_pk_bf16_f32 v134, v152, v153
  ds_read_b64_tr_b16 v[136:137], v158 offset:4096
  ds_read_b64_tr_b16 v[138:139], v158 offset:6144
  s_waitcnt lgkmcnt(6)
  v_mfma_f32_32x32x16_bf16 v[48:63], v[140:143], v[128:131], v[48:63]
  v_add_f32 v164, v164, v154
  v_add_f32 v164, v164, v155
  v_cvt_pk_bf16_f32 v135, v154, v155
  v_cmp_lt_f32 vcc, s60, v164
  s_cbranch_vccnz L_rareC2e
L_backC2e:
  v_add_f32 v163, v163, v164
  v_mbcnt_lo_u32_b32 v0, -1, 0
  v_mbcnt_hi_u32_b32 v0, -1, v0
  v_lshlrev_b32 v0, 4, v0
  s_lshl_b32 s50, s37, 3
  v_mov_b32 v6, s50
  ds_read_b64_tr_b16 v[140:141], v159 offset:4096
  ds_read_b64_tr_b16 v[142:143], v159 offset:6144
  s_waitcnt lgkmcnt(6)
  v_mfma_f32_32x32x16_bf16 v[64:79], v[144:147], v[128:131], v[64:79]
  v_fma_f32 v112, v96, s44, -v162
  v_fma_f32 v113, v97, s44, -v162
  v_fma_f32 v114, v98, s44, -v162
  v_fma_f32 v115, v99, s44, -v162
  v_exp_f32 v152, v112
  s_lshl_b32 s50, s36, 12
  v_add_u32 v2, s50, v0
  s_lshl_b32 s50, s85, 12
  v_add_u32 v3, s50, v0
  ds_read_b64_tr_b16 v[144:145], v160 offset:4096
  ds_read_b64_tr_b16 v[146:147], v160 offset:6144
  s_waitcnt lgkmcnt(6)
  v_mfma_f32_32x32x16_bf16 v[80:95], v[148:151], v[128:131], v[80:95]
  v_exp_f32 v153, v113
  v_fma_f32 v116, v100, s44, -v162
  v_fma_f32 v117, v101, s44, -v162
  s_lshl_b32 s50, s85, 10
  s_add_u32 s50, s50, 139520
  v_add_u32 v8, s50, v0
  s_lshl_b32 s50, s36, 10
  s_add_u32 s50, s50, 139520
  v_add_u32 v9, s50, v0
  ds_read_b64_tr_b16 v[148:149], v161 offset:4096
  ds_read_b64_tr_b16 v[150:151], v161 offset:6144
  s_waitcnt lgkmcnt(6)
  v_mfma_f32_32x32x16_bf16 v[32:47], v[136:139], v[132:135], v[32:47]
  s_and_b32 s50, s81, 3
  s_cmp_eq_u32 s50, 3
  s_cselect_b32 s86, s84, 17408
  s_mov_b32 s86, 69632
  v_fma_f32 v118, v102, s44, -v162
  v_fma_f32 v119, v103, s44, -v162
  v_exp_f32 v154, v114
  v_exp_f32 v155, v115
  v_lshrrev_b32 v1, 1, v0
  v_and_b32 v1, 0xf8, v1
  s_xor_b32 s55, s62, 1
  s_lshl_b32 s55, s55, 3
  s_add_u32 s55, s55, s36
  s_lshl_b32 s88, s55, 12
  s_xor_b32 s55, s62, 2
  s_lshl_b32 s55, s55, 3
  s_add_u32 s55, s55, s36
  s_lshl_b32 s89, s55, 12
  s_xor_b32 s55, s62, 3
  s_lshl_b32 s55, s55, 3
  s_add_u32 s55, s55, s36
  s_lshl_b32 s90, s55, 12
  s_waitcnt lgkmcnt(4)
  v_mfma_f32_32x32x16_bf16 v[48:63], v[140:143], v[132:135], v[48:63]
  v_add_u32 v158, s86, v158
  v_add_u32 v159, s86, v159
  v_fma_f32 v120, v104, s44, -v162
  v_fma_f32 v121, v105, s44, -v162
  s_waitcnt lgkmcnt(2)
  v_mfma_f32_32x32x16_bf16 v[64:79], v[144:147], v[132:135], v[64:79]
  v_add_u32 v160, s86, v160
  v_add_u32 v161, s86, v161
  v_fma_f32 v122, v106, s44, -v162
  v_fma_f32 v123, v107, s44, -v162
  v_add_f32 v164, v152, v153
  s_waitcnt lgkmcnt(0)
  v_mfma_f32_32x32x16_bf16 v[80:95], v[148:151], v[132:135], v[80:95]
  v_cvt_pk_bf16_f32 v128, v152, v153
  v_fma_f32 v124, v108, s44, -v162
  v_fma_f32 v125, v109, s44, -v162
  v_fma_f32 v126, v110, s44, -v162
  v_fma_f32 v127, v111, s44, -v162
  ds_read_b64_tr_b16 v[136:137], v161 offset:0
  ds_read_b64_tr_b16 v[138:139], v161 offset:2048
  ds_read_b64_tr_b16 v[140:141], v161 offset:4096
  ds_read_b64_tr_b16 v[142:143], v161 offset:6144
  ds_read_b64_tr_b16 v[144:145], v160 offset:0
  ds_read_b64_tr_b16 v[146:147], v160 offset:2048
  v_exp_f32 v152, v116
  v_exp_f32 v153, v117
  v_add_f32 v164, v164, v154
  v_add_f32 v164, v164, v155
  v_cvt_pk_bf16_f32 v129, v154, v155
  v_exp_f32 v154, v118
  v_exp_f32 v155, v119
  v_add_f32 v164, v164, v152
  v_add_f32 v164, v164, v153
  v_cvt_pk_bf16_f32 v130, v152, v153
  v_exp_f32 v152, v120
  v_exp_f32 v153, v121
  v_add_f32 v164, v164, v154
  v_add_f32 v164, v164, v155
  v_cvt_pk_bf16_f32 v131, v154, v155
  v_cmp_lt_f32 vcc, s60, v164
  s_cbranch_vccnz L_rareC1f
L_backC1f:
  v_add_f32 v163, v163, v164
  v_exp_f32 v154, v122
  v_exp_f32 v155, v123
  v_add_f32 v164, v152, v153
  v_cvt_pk_bf16_f32 v132, v152, v153
  v_exp_f32 v152, v124
  v_exp_f32 v153, v125
  v_add_f32 v164, v164, v154
  v_add_f32 v164, v164, v155
  v_cvt_pk_bf16_f32 v133, v154, v155
  v_exp_f32 v154, v126
  v_exp_f32 v155, v127
  v_add_f32 v164, v164, v152
  v_add_f32 v164, v164, v153
  v_cvt_pk_bf16_f32 v134, v152, v153
  v_add_f32 v164, v164, v154
  v_add_f32 v164, v164, v155
  v_cvt_pk_bf16_f32 v135, v154, v155
  v_cmp_lt_f32 vcc, s60, v164
  s_cbranch_vccnz L_rareC2f
L_backC2f:
  v_add_f32 v163, v163, v164
  ds_write_b64 v8, v[162:163]
  ds_read_b64_tr_b16 v[148:149], v160 offset:4096
  ds_read_b64_tr_b16 v[150:151], v160 offset:6144
  s_waitcnt lgkmcnt(7)
  v_mfma_f32_32x32x16_bf16 v[80:95], v[136:139], v[128:131], v[80:95]
  s_waitcnt lgkmcnt(2)
  s_barrier
  ds_read_b64 v[164:165], v9
  global_load_dwordx2 v[4:5], v6, s[12:13] sc1
  ds_read_b64_tr_b16 v[136:137], v159 offset:0
  ds_read_b64_tr_b16 v[138:139], v159 offset:2048
  v_mfma_f32_32x32x16_bf16 v[80:95], v[140:143], v[132:135], v[80:95]
  ds_read_b64_tr_b16 v[140:141], v159 offset:4096
  ds_read_b64_tr_b16 v[142:143], v159 offset:6144
  v_mfma_f32_32x32x16_bf16 v[64:79], v[144:147], v[128:131], v[64:79]
  s_waitcnt lgkmcnt(4)
  v_max_f32 v152, v162, v164
  v_sub_f32 v7, v162, v152
  v_sub_f32 v164, v164, v152
  v_exp_f32 v7, v7
  v_exp_f32 v164, v164
  v_mov_b32 v162, v152
  ds_read_b64_tr_b16 v[144:145], v158 offset:0
  ds_read_b64_tr_b16 v[146:147], v158 offset:2048
  v_mfma_f32_32x32x16_bf16 v[64:79], v[148:151], v[132:135], v[64:79]
  v_mul_f32 v80, v80, v7
  v_mul_f32 v81, v81, v7
  v_mul_f32 v82, v82, v7
  v_mul_f32 v83, v83, v7
  v_mul_f32 v84, v84, v7
  v_mul_f32 v85, v85, v7
  v_mul_f32 v86, v86, v7
  v_mul_f32 v87, v87, v7
  v_mul_f32 v88, v88, v7
  v_mul_f32 v89, v89, v7
  v_mul_f32 v90, v90, v7
  v_mul_f32 v91, v91, v7
  v_mul_f32 v92, v92, v7
  v_mul_f32 v93, v93, v7
  v_mul_f32 v94, v94, v7
  v_mul_f32 v95, v95, v7
  ds_read_b64_tr_b16 v[148:149], v158 offset:4096
  ds_read_b64_tr_b16 v[150:151], v158 offset:6144
  s_waitcnt lgkmcnt(6)
  v_mfma_f32_32x32x16_bf16 v[48:63], v[136:139], v[128:131], v[48:63]
  v_cvt_pk_bf16_f32 v104, v80, v81
  v_cvt_pk_bf16_f32 v105, v82, v83
  v_cvt_pk_bf16_f32 v106, v84, v85
  v_cvt_pk_bf16_f32 v107, v86, v87
  v_cvt_pk_bf16_f32 v108, v88, v89
  v_cvt_pk_bf16_f32 v109, v90, v91
  v_cvt_pk_bf16_f32 v110, v92, v93
  v_cvt_pk_bf16_f32 v111, v94, v95
  ds_write_b128 v3, v[104:107] offset:2048
  ds_write_b128 v3, v[108:111] offset:3072
  s_waitcnt lgkmcnt(6)
  v_mfma_f32_32x32x16_bf16 v[48:63], v[140:143], v[132:135], v[48:63]
  v_mul_f32 v64, v64, v7
  v_mul_f32 v65, v65, v7
  v_mul_f32 v66, v66, v7
  v_mul_f32 v67, v67, v7
  v_mul_f32 v68, v68, v7
  v_mul_f32 v69, v69, v7
  v_mul_f32 v70, v70, v7
  v_mul_f32 v71, v71, v7
  v_mul_f32 v72, v72, v7
  v_mul_f32 v73, v73, v7
  v_mul_f32 v74, v74, v7
  v_mul_f32 v75, v75, v7
  v_mul_f32 v76, v76, v7
  v_mul_f32 v77, v77, v7
  v_mul_f32 v78, v78, v7
  v_mul_f32 v79, v79, v7
  s_waitcnt lgkmcnt(4)
  v_mfma_f32_32x32x16_bf16 v[32:47], v[144:147], v[128:131], v[32:47]
  v_cvt_pk_bf16_f32 v96, v64, v65
  v_cvt_pk_bf16_f32 v97, v66, v67
  v_cvt_pk_bf16_f32 v98, v68, v69
  v_cvt_pk_bf16_f32 v99, v70, v71
  v_cvt_pk_bf16_f32 v100, v72, v73
  v_cvt_pk_bf16_f32 v101, v74, v75
  v_cvt_pk_bf16_f32 v102, v76, v77
  v_cvt_pk_bf16_f32 v103, v78, v79
  ds_write_b128 v3, v[96:99] offset:0
  ds_write_b128 v3, v[100:103] offset:1024
  s_waitcnt lgkmcnt(4)
  v_mfma_f32_32x32x16_bf16 v[32:47], v[148:151], v[132:135], v[32:47]
  v_mul_f32 v163, v163, v7
  v_fmac_f32 v163, v164, v165
  v_mov_b32 v165, v163
  v_min_u32 v162, -2, v162
  s_nop 0
  v_permlane32_swap_b32 v163, v165
  v_add_f32 v163, v163, v165
  v_min_u32 v163, -2, v163
  s_waitcnt lgkmcnt(0)
  s_barrier
  ds_read_b128 v[100:103], v2 offset:1024
  ds_read_b128 v[104:107], v2 offset:2048
  ds_read_b128 v[108:111], v2 offset:3072
  ds_read_b128 v[96:99], v2 offset:0
  s_waitcnt vmcnt(0)
  s_mov_b32 s58, 262144
  v_readfirstlane_b32 s46, v4
  v_readfirstlane_b32 s47, v5
  s_cmp_lg_u32 s47, 8
  s_cbranch_scc1 L_gw
  s_nop 2
L_gw_ok:
  s_cmp_eq_u32 s46, s48
  s_cbranch_scc0 L_slow
  buffer_store_dwordx2 v[162:163], v1, s[32:35], s80 offen offset:3072
  s_waitcnt lgkmcnt(3)
  v_lshlrev_b32 v152, 16, v100
  v_and_b32 v153, 0xffff0000, v100
  v_fma_f32 v40, v40, v7, v152
  v_fma_f32 v41, v41, v7, v153
  v_lshlrev_b32 v152, 16, v101
  v_and_b32 v153, 0xffff0000, v101
  v_fma_f32 v42, v42, v7, v152
  v_fma_f32 v43, v43, v7, v153
  v_lshlrev_b32 v152, 16, v102
  v_and_b32 v153, 0xffff0000, v102
  v_fma_f32 v44, v44, v7, v152
  v_fma_f32 v45, v45, v7, v153
  v_lshlrev_b32 v152, 16, v103
  v_and_b32 v153, 0xffff0000, v103
  v_fma_f32 v46, v46, v7, v152
  v_fma_f32 v47, v47, v7, v153
  v_cvt_pk_bf16_f32 v16, v40, v41
  v_cvt_pk_bf16_f32 v17, v42, v43
  v_cvt_pk_bf16_f32 v18, v44, v45
  v_cvt_pk_bf16_f32 v19, v46, v47
  v_min_u32 v16, -2, v16
  v_min_u32 v17, -2, v17
  v_min_u32 v18, -2, v18
  v_min_u32 v19, -2, v19
  buffer_store_dwordx4 v[16:19], v0, s[32:35], s80 offen offset:0
  s_waitcnt lgkmcnt(2)
  v_lshlrev_b32 v152, 16, v104
  v_and_b32 v153, 0xffff0000, v104
  v_fma_f32 v48, v48, v7, v152
  v_fma_f32 v49, v49, v7, v153
  v_lshlrev_b32 v152, 16, v105
  v_and_b32 v153, 0xffff0000, v105
  v_fma_f32 v50, v50, v7, v152
  v_fma_f32 v51, v51, v7, v153
  v_lshlrev_b32 v152, 16, v106
  v_and_b32 v153, 0xffff0000, v106
  v_fma_f32 v52, v52, v7, v152
  v_fma_f32 v53, v53, v7, v153
  v_lshlrev_b32 v152, 16, v107
  v_and_b32 v153, 0xffff0000, v107
  v_fma_f32 v54, v54, v7, v152
  v_fma_f32 v55, v55, v7, v153
  v_cvt_pk_bf16_f32 v20, v48, v49
  v_cvt_pk_bf16_f32 v21, v50, v51
  v_cvt_pk_bf16_f32 v22, v52, v53
  v_cvt_pk_bf16_f32 v23, v54, v55
  v_min_u32 v20, -2, v20
  v_min_u32 v21, -2, v21
  v_min_u32 v22, -2, v22
  v_min_u32 v23, -2, v23
  buffer_store_dwordx4 v[20:23], v0, s[32:35], s80 offen offset:1024
  s_waitcnt lgkmcnt(1)
  v_lshlrev_b32 v152, 16, v108
  v_and_b32 v153, 0xffff0000, v108
  v_fma_f32 v56, v56, v7, v152
  v_fma_f32 v57, v57, v7, v153
  v_lshlrev_b32 v152, 16, v109
  v_and_b32 v153, 0xffff0000, v109
  v_fma_f32 v58, v58, v7, v152
  v_fma_f32 v59, v59, v7, v153
  v_lshlrev_b32 v152, 16, v110
  v_and_b32 v153, 0xffff0000, v110
  v_fma_f32 v60, v60, v7, v152
  v_fma_f32 v61, v61, v7, v153
  v_lshlrev_b32 v152, 16, v111
  v_and_b32 v153, 0xffff0000, v111
  v_fma_f32 v62, v62, v7, v152
  v_fma_f32 v63, v63, v7, v153
  v_cvt_pk_bf16_f32 v24, v56, v57
  v_cvt_pk_bf16_f32 v25, v58, v59
  v_cvt_pk_bf16_f32 v26, v60, v61
  v_cvt_pk_bf16_f32 v27, v62, v63
  v_min_u32 v24, -2, v24
  v_min_u32 v25, -2, v25
  v_min_u32 v26, -2, v26
  v_min_u32 v27, -2, v27
  buffer_store_dwordx4 v[24:27], v0, s[32:35], s80 offen offset:2048
  s_waitcnt lgkmcnt(0)
  v_lshlrev_b32 v152, 16, v96
  v_and_b32 v153, 0xffff0000, v96
  v_fma_f32 v32, v32, v7, v152
  v_fma_f32 v33, v33, v7, v153
  v_lshlrev_b32 v152, 16, v97
  v_and_b32 v153, 0xffff0000, v97
  v_fma_f32 v34, v34, v7, v152
  v_fma_f32 v35, v35, v7, v153
  v_lshlrev_b32 v152, 16, v98
  v_and_b32 v153, 0xffff0000, v98
  v_fma_f32 v36, v36, v7, v152
  v_fma_f32 v37, v37, v7, v153
  v_lshlrev_b32 v152, 16, v99
  v_and_b32 v153, 0xffff0000, v99
  v_fma_f32 v38, v38, v7, v152
  v_fma_f32 v39, v39, v7, v153
  s_nop 1
L_pub_done:
  s_mov_b32 s58, 262144
L_poll:
  buffer_load_dwordx2 v[138:139], v1, s[32:35], s88 offen offset:3072 sc1
  buffer_load_dwordx4 v[64:67], v0, s[32:35], s88 offen offset:0 sc1
  buffer_load_dwordx2 v[140:141], v1, s[32:35], s89 offen offset:3072 sc1
  buffer_load_dwordx4 v[68:71], v0, s[32:35], s89 offen offset:1024 sc1
  buffer_load_dwordx2 v[142:143], v1, s[32:35], s90 offen offset:3072 sc1
  buffer_load_dwordx4 v[72:75], v0, s[32:35], s90 offen offset:2048 sc1
  s_sub_u32 s58, s58, 1
  s_cmp_eq_u32 s58, 0
  s_cbranch_scc1 L_poll_done
  s_waitcnt vmcnt(0)
  v_max3_u32 v152, v138, v139, v140
  v_max3_u32 v152, v152, v141, v142
  v_max3_u32 v152, v152, v143, v64
  v_max3_u32 v152, v152, v65, v66
  v_max3_u32 v152, v152, v67, v68
  v_max3_u32 v152, v152, v69, v70
  v_max3_u32 v152, v152, v71, v72
  v_max3_u32 v152, v152, v73, v74
  v_max_u32 v152, v152, v75
  v_cmp_eq_u32 vcc, -1, v152
  s_cbranch_vccnz L_poll
  s_nop 3
L_poll_done:
  s_waitcnt vmcnt(0)
  v_max3_f32 v152, v162, v138, v140
  v_max_f32 v152, v152, v142
  v_sub_f32 v136, v162, v152
  v_sub_f32 v138, v138, v152
  v_sub_f32 v140, v140, v152
  v_sub_f32 v142, v142, v152
  v_exp_f32 v136, v136
  v_exp_f32 v138, v138
  v_exp_f32 v140, v140
  v_exp_f32 v142, v142
  v_mul_f32 v153, v136, v163
  v_fmac_f32 v153, v138, v139
  v_fmac_f32 v153, v140, v141
  v_fmac_f32 v153, v142, v143
  v_rcp_f32 v153, v153
  v_mul_f32 v32, v32, v136
  v_mul_f32 v33, v33, v136
  v_mul_f32 v34, v34, v136
  v_mul_f32 v35, v35, v136
  v_mul_f32 v36, v36, v136
  v_mul_f32 v37, v37, v136
  v_mul_f32 v38, v38, v136
  v_mul_f32 v39, v39, v136
  v_lshlrev_b32 v154, 16, v64
  v_and_b32 v155, 0xffff0000, v64
  v_fmac_f32 v32, v154, v138
  v_fmac_f32 v33, v155, v138
  v_lshlrev_b32 v154, 16, v65
  v_and_b32 v155, 0xffff0000, v65
  v_fmac_f32 v34, v154, v138
  v_fmac_f32 v35, v155, v138
  v_lshlrev_b32 v154, 16, v66
  v_and_b32 v155, 0xffff0000, v66
  v_fmac_f32 v36, v154, v138
  v_fmac_f32 v37, v155, v138
  v_lshlrev_b32 v154, 16, v67
  v_and_b32 v155, 0xffff0000, v67
  v_fmac_f32 v38, v154, v138
  v_fmac_f32 v39, v155, v138
  v_lshlrev_b32 v154, 16, v68
  v_and_b32 v155, 0xffff0000, v68
  v_fmac_f32 v32, v154, v140
  v_fmac_f32 v33, v155, v140
  v_lshlrev_b32 v154, 16, v69
  v_and_b32 v155, 0xffff0000, v69
  v_fmac_f32 v34, v154, v140
  v_fmac_f32 v35, v155, v140
  v_lshlrev_b32 v154, 16, v70
  v_and_b32 v155, 0xffff0000, v70
  v_fmac_f32 v36, v154, v140
  v_fmac_f32 v37, v155, v140
  v_lshlrev_b32 v154, 16, v71
  v_and_b32 v155, 0xffff0000, v71
  v_fmac_f32 v38, v154, v140
  v_fmac_f32 v39, v155, v140
  v_lshlrev_b32 v154, 16, v72
  v_and_b32 v155, 0xffff0000, v72
  v_fmac_f32 v32, v154, v142
  v_fmac_f32 v33, v155, v142
  v_lshlrev_b32 v154, 16, v73
  v_and_b32 v155, 0xffff0000, v73
  v_fmac_f32 v34, v154, v142
  v_fmac_f32 v35, v155, v142
  v_lshlrev_b32 v154, 16, v74
  v_and_b32 v155, 0xffff0000, v74
  v_fmac_f32 v36, v154, v142
  v_fmac_f32 v37, v155, v142
  v_lshlrev_b32 v154, 16, v75
  v_and_b32 v155, 0xffff0000, v75
  v_fmac_f32 v38, v154, v142
  v_fmac_f32 v39, v155, v142
  v_mul_f32 v32, v32, v153
  v_mul_f32 v33, v33, v153
  v_mul_f32 v34, v34, v153
  v_mul_f32 v35, v35, v153
  v_mul_f32 v36, v36, v153
  v_mul_f32 v37, v37, v153
  v_mul_f32 v38, v38, v153
  v_mul_f32 v39, v39, v153
  v_cvt_pk_bf16_f32 v12, v32, v33
  v_cvt_pk_bf16_f32 v13, v34, v35
  v_cvt_pk_bf16_f32 v14, v36, v37
  v_cvt_pk_bf16_f32 v15, v38, v39
  v_lshlrev_b32 v152, 5, v1
  v_lshrrev_b32 v153, 9, v0
  v_lshl_add_u32 v152, v153, 3, v152
  s_lshl_b32 s50, s40, 13
  s_lshl_b32 s51, s41, 7
  s_add_u32 s50, s50, s51
  s_lshl_b32 s51, s38, 5
  s_add_u32 s50, s50, s51
  buffer_store_dwordx2 v[12:13], v152, s[28:31], s50 offen
  buffer_store_dwordx2 v[14:15], v152, s[28:31], s50 offen offset:16
L_done:
  s_endpgm
L_gw:
  s_sub_u32 s58, s58, 1
  s_cmp_eq_u32 s58, 0
  s_cbranch_scc1 L_gw_ok
  s_sleep 2
  global_load_dwordx2 v[4:5], v6, s[12:13] sc1
  s_waitcnt vmcnt(0)
  v_readfirstlane_b32 s46, v4
  v_readfirstlane_b32 s47, v5
  s_cmp_lg_u32 s47, 8
  s_cbranch_scc1 L_gw
  s_branch L_gw_ok
  s_nop 1
L_slow:
  buffer_store_dwordx2 v[162:163], v1, s[32:35], s80 offen offset:3072 sc1
  s_waitcnt lgkmcnt(3)
  v_lshlrev_b32 v152, 16, v100
  v_and_b32 v153, 0xffff0000, v100
  v_fma_f32 v40, v40, v7, v152
  v_fma_f32 v41, v41, v7, v153
  v_lshlrev_b32 v152, 16, v101
  v_and_b32 v153, 0xffff0000, v101
  v_fma_f32 v42, v42, v7, v152
  v_fma_f32 v43, v43, v7, v153
  v_lshlrev_b32 v152, 16, v102
  v_and_b32 v153, 0xffff0000, v102
  v_fma_f32 v44, v44, v7, v152
  v_fma_f32 v45, v45, v7, v153
  v_lshlrev_b32 v152, 16, v103
  v_and_b32 v153, 0xffff0000, v103
  v_fma_f32 v46, v46, v7, v152
  v_fma_f32 v47, v47, v7, v153
  v_cvt_pk_bf16_f32 v16, v40, v41
  v_cvt_pk_bf16_f32 v17, v42, v43
  v_cvt_pk_bf16_f32 v18, v44, v45
  v_cvt_pk_bf16_f32 v19, v46, v47
  v_min_u32 v16, -2, v16
  v_min_u32 v17, -2, v17
  v_min_u32 v18, -2, v18
  v_min_u32 v19, -2, v19
  buffer_store_dwordx4 v[16:19], v0, s[32:35], s80 offen offset:0 sc1
  s_waitcnt lgkmcnt(2)
  v_lshlrev_b32 v152, 16, v104
  v_and_b32 v153, 0xffff0000, v104
  v_fma_f32 v48, v48, v7, v152
  v_fma_f32 v49, v49, v7, v153
  v_lshlrev_b32 v152, 16, v105
  v_and_b32 v153, 0xffff0000, v105
  v_fma_f32 v50, v50, v7, v152
  v_fma_f32 v51, v51, v7, v153
  v_lshlrev_b32 v152, 16, v106
  v_and_b32 v153, 0xffff0000, v106
  v_fma_f32 v52, v52, v7, v152
  v_fma_f32 v53, v53, v7, v153
  v_lshlrev_b32 v152, 16, v107
  v_and_b32 v153, 0xffff0000, v107
  v_fma_f32 v54, v54, v7, v152
  v_fma_f32 v55, v55, v7, v153
  v_cvt_pk_bf16_f32 v20, v48, v49
  v_cvt_pk_bf16_f32 v21, v50, v51
  v_cvt_pk_bf16_f32 v22, v52, v53
  v_cvt_pk_bf16_f32 v23, v54, v55
  v_min_u32 v20, -2, v20
  v_min_u32 v21, -2, v21
  v_min_u32 v22, -2, v22
  v_min_u32 v23, -2, v23
  buffer_store_dwordx4 v[20:23], v0, s[32:35], s80 offen offset:1024 sc1
  s_waitcnt lgkmcnt(1)
  v_lshlrev_b32 v152, 16, v108
  v_and_b32 v153, 0xffff0000, v108
  v_fma_f32 v56, v56, v7, v152
  v_fma_f32 v57, v57, v7, v153
  v_lshlrev_b32 v152, 16, v109
  v_and_b32 v153, 0xffff0000, v109
  v_fma_f32 v58, v58, v7, v152
  v_fma_f32 v59, v59, v7, v153
  v_lshlrev_b32 v152, 16, v110
  v_and_b32 v153, 0xffff0000, v110
  v_fma_f32 v60, v60, v7, v152
  v_fma_f32 v61, v61, v7, v153
  v_lshlrev_b32 v152, 16, v111
  v_and_b32 v153, 0xffff0000, v111
  v_fma_f32 v62, v62, v7, v152
  v_fma_f32 v63, v63, v7, v153
  v_cvt_pk_bf16_f32 v24, v56, v57
  v_cvt_pk_bf16_f32 v25, v58, v59
  v_cvt_pk_bf16_f32 v26, v60, v61
  v_cvt_pk_bf16_f32 v27, v62, v63
  v_min_u32 v24, -2, v24
  v_min_u32 v25, -2, v25
  v_min_u32 v26, -2, v26
  v_min_u32 v27, -2, v27
  buffer_store_dwordx4 v[24:27], v0, s[32:35], s80 offen offset:2048 sc1
  s_waitcnt lgkmcnt(0)
  v_lshlrev_b32 v152, 16, v96
  v_and_b32 v153, 0xffff0000, v96
  v_fma_f32 v32, v32, v7, v152
  v_fma_f32 v33, v33, v7, v153
  v_lshlrev_b32 v152, 16, v97
  v_and_b32 v153, 0xffff0000, v97
  v_fma_f32 v34, v34, v7, v152
  v_fma_f32 v35, v35, v7, v153
  v_lshlrev_b32 v152, 16, v98
  v_and_b32 v153, 0xffff0000, v98
  v_fma_f32 v36, v36, v7, v152
  v_fma_f32 v37, v37, v7, v153
  v_lshlrev_b32 v152, 16, v99
  v_and_b32 v153, 0xffff0000, v99
  v_fma_f32 v38, v38, v7, v152
  v_fma_f32 v39, v39, v7, v153
  s_branch L_pub_done
  s_nop 0
L_rareC2l:
  s_nop 15
  v_max3_f32 v152, v112, v113, v114
  v_max3_f32 v153, v115, v116, v117
  v_max3_f32 v152, v152, v118, v119
  v_max3_f32 v153, v153, v120, v121
  v_max3_f32 v152, v152, v122, v123
  v_max3_f32 v153, v153, v124, v125
  v_max3_f32 v152, v152, v126, v127
  v_max_f32 v152, v152, v153
  v_mov_b32 v153, v152
  s_nop 1
  v_permlane32_swap_b32 v152, v153
  v_max_f32 v152, v152, v153
  v_max_f32 v152, 0, v152
  v_sub_f32 v153, 0, v152
  v_exp_f32 v153, v153
  v_add_f32 v162, v162, v152
  v_mul_f32 v163, v163, v153
  v_mul_f32 v32, v32, v153
  v_mul_f32 v33, v33, v153
  v_mul_f32 v34, v34, v153
  v_mul_f32 v35, v35, v153
  v_mul_f32 v36, v36, v153
  v_mul_f32 v37, v37, v153
  v_mul_f32 v38, v38, v153
  v_mul_f32 v39, v39, v153
  v_mul_f32 v40, v40, v153
  v_mul_f32 v41, v41, v153
  v_mul_f32 v42, v42, v153
  v_mul_f32 v43, v43, v153
  v_mul_f32 v44, v44, v153
  v_mul_f32 v45, v45, v153
  v_mul_f32 v46, v46, v153
  v_mul_f32 v47, v47, v153
  v_mul_f32 v48, v48, v153
  v_mul_f32 v49, v49, v153
  v_mul_f32 v50, v50, v153
  v_mul_f32 v51, v51, v153
  v_mul_f32 v52, v52, v153
  v_mul_f32 v53, v53, v153
  v_mul_f32 v54, v54, v153
  v_mul_f32 v55, v55, v153
  v_mul_f32 v56, v56, v153
  v_mul_f32 v57, v57, v153
  v_mul_f32 v58, v58, v153
  v_mul_f32 v59, v59, v153
  v_mul_f32 v60, v60, v153
  v_mul_f32 v61, v61, v153
  v_mul_f32 v62, v62, v153
  v_mul_f32 v63, v63, v153
  v_mul_f32 v64, v64, v153
  v_mul_f32 v65, v65, v153
  v_mul_f32 v66, v66, v153
  v_mul_f32 v67, v67, v153
  v_mul_f32 v68, v68, v153
  v_mul_f32 v69, v69, v153
  v_mul_f32 v70, v70, v153
  v_mul_f32 v71, v71, v153
  v_mul_f32 v72, v72, v153
  v_mul_f32 v73, v73, v153
  v_mul_f32 v74, v74, v153
  v_mul_f32 v75, v75, v153
  v_mul_f32 v76, v76, v153
  v_mul_f32 v77, v77, v153
  v_mul_f32 v78, v78, v153
  v_mul_f32 v79, v79, v153
  v_mul_f32 v80, v80, v153
  v_mul_f32 v81, v81, v153
  v_mul_f32 v82, v82, v153
  v_mul_f32 v83, v83, v153
  v_mul_f32 v84, v84, v153
  v_mul_f32 v85, v85, v153
  v_mul_f32 v86, v86, v153
  v_mul_f32 v87, v87, v153
  v_mul_f32 v88, v88, v153
  v_mul_f32 v89, v89, v153
  v_mul_f32 v90, v90, v153
  v_mul_f32 v91, v91, v153
  v_mul_f32 v92, v92, v153
  v_mul_f32 v93, v93, v153
  v_mul_f32 v94, v94, v153
  v_mul_f32 v95, v95, v153
  v_sub_f32 v112, v112, v152
  v_sub_f32 v113, v113, v152
  v_sub_f32 v114, v114, v152
  v_sub_f32 v115, v115, v152
  v_sub_f32 v116, v116, v152
  v_sub_f32 v117, v117, v152
  v_sub_f32 v118, v118, v152
  v_sub_f32 v119, v119, v152
  v_sub_f32 v120, v120, v152
  v_sub_f32 v121, v121, v152
  v_sub_f32 v122, v122, v152
  v_sub_f32 v123, v123, v152
  v_sub_f32 v124, v124, v152
  v_sub_f32 v125, v125, v152
  v_sub_f32 v126, v126, v152
  v_sub_f32 v127, v127, v152
  v_exp_f32 v152, v112
  v_exp_f32 v153, v113
  s_nop 0
  v_add_f32 v164, v152, v153
  v_cvt_pk_bf16_f32 v128, v152, v153
  v_exp_f32 v154, v114
  v_exp_f32 v155, v115
  v_add_f32 v164, v164, v154
  v_add_f32 v164, v164, v155
  v_cvt_pk_bf16_f32 v129, v154, v155
  v_exp_f32 v152, v116
  v_exp_f32 v153, v117
  v_add_f32 v164, v164, v152
  v_add_f32 v164, v164, v153
  v_cvt_pk_bf16_f32 v130, v152, v153
  v_exp_f32 v154, v118
  v_exp_f32 v155, v119
  v_add_f32 v164, v164, v154
  v_add_f32 v164, v164, v155
  v_cvt_pk_bf16_f32 v131, v154, v155
  v_exp_f32 v152, v120
  v_exp_f32 v153, v121
  s_nop 0
  v_add_f32 v164, v152, v153
  v_cvt_pk_bf16_f32 v132, v152, v153
  v_exp_f32 v154, v122
  v_exp_f32 v155, v123
  v_add_f32 v164, v164, v154
  v_add_f32 v164, v164, v155
  v_cvt_pk_bf16_f32 v133, v154, v155
  v_exp_f32 v152, v124
  v_exp_f32 v153, v125
  v_add_f32 v164, v164, v152
  v_add_f32 v164, v164, v153
  v_cvt_pk_bf16_f32 v134, v152, v153
  v_exp_f32 v154, v126
  v_exp_f32 v155, v127
  v_add_f32 v164, v164, v154
  v_add_f32 v164, v164, v155
  v_cvt_pk_bf16_f32 v135, v154, v155
  s_nop 1
  s_branch L_backC2l
L_rareC1l:
  s_nop 15
  v_max3_f32 v152, v112, v113, v114
  v_max3_f32 v153, v115, v116, v117
  v_max3_f32 v152, v152, v118, v119
  v_max3_f32 v153, v153, v120, v121
  v_max3_f32 v152, v152, v122, v123
  v_max3_f32 v153, v153, v124, v125
  v_max3_f32 v152, v152, v126, v127
  v_max_f32 v152, v152, v153
  v_mov_b32 v153, v152
  s_nop 1
  v_permlane32_swap_b32 v152, v153
  v_max_f32 v152, v152, v153
  v_max_f32 v152, 0, v152
  v_sub_f32 v153, 0, v152
  v_exp_f32 v153, v153
  v_add_f32 v162, v162, v152
  v_mul_f32 v163, v163, v153
  v_mul_f32 v32, v32, v153
  v_mul_f32 v33, v33, v153
  v_mul_f32 v34, v34, v153
  v_mul_f32 v35, v35, v153
  v_mul_f32 v36, v36, v153
  v_mul_f32 v37, v37, v153
  v_mul_f32 v38, v38, v153
  v_mul_f32 v39, v39, v153
  v_mul_f32 v40, v40, v153
  v_mul_f32 v41, v41, v153
  v_mul_f32 v42, v42, v153
  v_mul_f32 v43, v43, v153
  v_mul_f32 v44, v44, v153
  v_mul_f32 v45, v45, v153
  v_mul_f32 v46, v46, v153
  v_mul_f32 v47, v47, v153
  v_mul_f32 v48, v48, v153
  v_mul_f32 v49, v49, v153
  v_mul_f32 v50, v50, v153
  v_mul_f32 v51, v51, v153
  v_mul_f32 v52, v52, v153
  v_mul_f32 v53, v53, v153
  v_mul_f32 v54, v54, v153
  v_mul_f32 v55, v55, v153
  v_mul_f32 v56, v56, v153
  v_mul_f32 v57, v57, v153
  v_mul_f32 v58, v58, v153
  v_mul_f32 v59, v59, v153
  v_mul_f32 v60, v60, v153
  v_mul_f32 v61, v61, v153
  v_mul_f32 v62, v62, v153
  v_mul_f32 v63, v63, v153
  v_mul_f32 v64, v64, v153
  v_mul_f32 v65, v65, v153
  v_mul_f32 v66, v66, v153
  v_mul_f32 v67, v67, v153
  v_mul_f32 v68, v68, v153
  v_mul_f32 v69, v69, v153
  v_mul_f32 v70, v70, v153
  v_mul_f32 v71, v71, v153
  v_mul_f32 v72, v72, v153
  v_mul_f32 v73, v73, v153
  v_mul_f32 v74, v74, v153
  v_mul_f32 v75, v75, v153
  v_mul_f32 v76, v76, v153
  v_mul_f32 v77, v77, v153
  v_mul_f32 v78, v78, v153
  v_mul_f32 v79, v79, v153
  v_mul_f32 v80, v80, v153
  v_mul_f32 v81, v81, v153
  v_mul_f32 v82, v82, v153
  v_mul_f32 v83, v83, v153
  v_mul_f32 v84, v84, v153
  v_mul_f32 v85, v85, v153
  v_mul_f32 v86, v86, v153
  v_mul_f32 v87, v87, v153
  v_mul_f32 v88, v88, v153
  v_mul_f32 v89, v89, v153
  v_mul_f32 v90, v90, v153
  v_mul_f32 v91, v91, v153
  v_mul_f32 v92, v92, v153
  v_mul_f32 v93, v93, v153
  v_mul_f32 v94, v94, v153
  v_mul_f32 v95, v95, v153
  v_sub_f32 v112, v112, v152
  v_sub_f32 v113, v113, v152
  v_sub_f32 v114, v114, v152
  v_sub_f32 v115, v115, v152
  v_sub_f32 v116, v116, v152
  v_sub_f32 v117, v117, v152
  v_sub_f32 v118, v118, v152
  v_sub_f32 v119, v119, v152
  v_sub_f32 v120, v120, v152
  v_sub_f32 v121, v121, v152
  v_sub_f32 v122, v122, v152
  v_sub_f32 v123, v123, v152
  v_sub_f32 v124, v124, v152
  v_sub_f32 v125, v125, v152
  v_sub_f32 v126, v126, v152
  v_sub_f32 v127, v127, v152
  v_exp_f32 v152, v112
  v_exp_f32 v153, v113
  s_nop 0
  v_add_f32 v164, v152, v153
  v_cvt_pk_bf16_f32 v128, v152, v153
  v_exp_f32 v154, v114
  v_exp_f32 v155, v115
  v_add_f32 v164, v164, v154
  v_add_f32 v164, v164, v155
  v_cvt_pk_bf16_f32 v129, v154, v155
  v_exp_f32 v152, v116
  v_exp_f32 v153, v117
  v_add_f32 v164, v164, v152
  v_add_f32 v164, v164, v153
  v_cvt_pk_bf16_f32 v130, v152, v153
  v_exp_f32 v154, v118
  v_exp_f32 v155, v119
  v_add_f32 v164, v164, v154
  v_add_f32 v164, v164, v155
  v_cvt_pk_bf16_f32 v131, v154, v155
  v_exp_f32 v152, v120
  v_exp_f32 v153, v121
  s_nop 1
  s_branch L_backC1l
L_rareC2e:
  s_nop 15
  v_max3_f32 v152, v112, v113, v114
  v_max3_f32 v153, v115, v116, v117
  v_max3_f32 v152, v152, v118, v119
  v_max3_f32 v153, v153, v120, v121
  v_max3_f32 v152, v152, v122, v123
  v_max3_f32 v153, v153, v124, v125
  v_max3_f32 v152, v152, v126, v127
  v_max_f32 v152, v152, v153
  v_mov_b32 v153, v152
  s_nop 1
  v_permlane32_swap_b32 v152, v153
  v_max_f32 v152, v152, v153
  v_max_f32 v152, 0, v152
  v_sub_f32 v153, 0, v152
  v_exp_f32 v153, v153
  v_add_f32 v162, v162, v152
  v_mul_f32 v163, v163, v153
  v_mul_f32 v32, v32, v153
  v_mul_f32 v33, v33, v153
  v_mul_f32 v34, v34, v153
  v_mul_f32 v35, v35, v153
  v_mul_f32 v36, v36, v153
  v_mul_f32 v37, v37, v153
  v_mul_f32 v38, v38, v153
  v_mul_f32 v39, v39, v153
  v_mul_f32 v40, v40, v153
  v_mul_f32 v41, v41, v153
  v_mul_f32 v42, v42, v153
  v_mul_f32 v43, v43, v153
  v_mul_f32 v44, v44, v153
  v_mul_f32 v45, v45, v153
  v_mul_f32 v46, v46, v153
  v_mul_f32 v47, v47, v153
  v_mul_f32 v48, v48, v153
  v_mul_f32 v49, v49, v153
  v_mul_f32 v50, v50, v153
  v_mul_f32 v51, v51, v153
  v_mul_f32 v52, v52, v153
  v_mul_f32 v53, v53, v153
  v_mul_f32 v54, v54, v153
  v_mul_f32 v55, v55, v153
  v_mul_f32 v56, v56, v153
  v_mul_f32 v57, v57, v153
  v_mul_f32 v58, v58, v153
  v_mul_f32 v59, v59, v153
  v_mul_f32 v60, v60, v153
  v_mul_f32 v61, v61, v153
  v_mul_f32 v62, v62, v153
  v_mul_f32 v63, v63, v153
  v_mul_f32 v64, v64, v153
  v_mul_f32 v65, v65, v153
  v_mul_f32 v66, v66, v153
  v_mul_f32 v67, v67, v153
  v_mul_f32 v68, v68, v153
  v_mul_f32 v69, v69, v153
  v_mul_f32 v70, v70, v153
  v_mul_f32 v71, v71, v153
  v_mul_f32 v72, v72, v153
  v_mul_f32 v73, v73, v153
  v_mul_f32 v74, v74, v153
  v_mul_f32 v75, v75, v153
  v_mul_f32 v76, v76, v153
  v_mul_f32 v77, v77, v153
  v_mul_f32 v78, v78, v153
  v_mul_f32 v79, v79, v153
  v_mul_f32 v80, v80, v153
  v_mul_f32 v81, v81, v153
  v_mul_f32 v82, v82, v153
  v_mul_f32 v83, v83, v153
  v_mul_f32 v84, v84, v153
  v_mul_f32 v85, v85, v153
  v_mul_f32 v86, v86, v153
  v_mul_f32 v87, v87, v153
  v_mul_f32 v88, v88, v153
  v_mul_f32 v89, v89, v153
  v_mul_f32 v90, v90, v153
  v_mul_f32 v91, v91, v153
  v_mul_f32 v92, v92, v153
  v_mul_f32 v93, v93, v153
  v_mul_f32 v94, v94, v153
  v_mul_f32 v95, v95, v153
  v_sub_f32 v112, v112, v152
  v_sub_f32 v113, v113, v152
  v_sub_f32 v114, v114, v152
  v_sub_f32 v115, v115, v152
  v_sub_f32 v116, v116, v152
  v_sub_f32 v117, v117, v152
  v_sub_f32 v118, v118, v152
  v_sub_f32 v119, v119, v152
  v_sub_f32 v120, v120, v152
  v_sub_f32 v121, v121, v152
  v_sub_f32 v122, v122, v152
  v_sub_f32 v123, v123, v152
  v_sub_f32 v124, v124, v152
  v_sub_f32 v125, v125, v152
  v_sub_f32 v126, v126, v152
  v_sub_f32 v127, v127, v152
  v_exp_f32 v152, v112
  v_exp_f32 v153, v113
  s_nop 0
  v_add_f32 v164, v152, v153
  v_cvt_pk_bf16_f32 v128, v152, v153
  v_exp_f32 v154, v114
  v_exp_f32 v155, v115
  v_add_f32 v164, v164, v154
  v_add_f32 v164, v164, v155
  v_cvt_pk_bf16_f32 v129, v154, v155
  v_exp_f32 v152, v116
  v_exp_f32 v153, v117
  v_add_f32 v164, v164, v152
  v_add_f32 v164, v164, v153
  v_cvt_pk_bf16_f32 v130, v152, v153
  v_exp_f32 v154, v118
  v_exp_f32 v155, v119
  v_add_f32 v164, v164, v154
  v_add_f32 v164, v164, v155
  v_cvt_pk_bf16_f32 v131, v154, v155
  v_exp_f32 v152, v120
  v_exp_f32 v153, v121
  s_nop 0
  v_add_f32 v164, v152, v153
  v_cvt_pk_bf16_f32 v132, v152, v153
  v_exp_f32 v154, v122
  v_exp_f32 v155, v123
  v_add_f32 v164, v164, v154
  v_add_f32 v164, v164, v155
  v_cvt_pk_bf16_f32 v133, v154, v155
  v_exp_f32 v152, v124
  v_exp_f32 v153, v125
  v_add_f32 v164, v164, v152
  v_add_f32 v164, v164, v153
  v_cvt_pk_bf16_f32 v134, v152, v153
  v_exp_f32 v154, v126
  v_exp_f32 v155, v127
  v_add_f32 v164, v164, v154
  v_add_f32 v164, v164, v155
  v_cvt_pk_bf16_f32 v135, v154, v155
  s_nop 1
  s_branch L_backC2e
L_rareC1f:
  s_nop 15
  v_max3_f32 v152, v112, v113, v114
  v_max3_f32 v153, v115, v116, v117
  v_max3_f32 v152, v152, v118, v119
  v_max3_f32 v153, v153, v120, v121
  v_max3_f32 v152, v152, v122, v123
  v_max3_f32 v153, v153, v124, v125
  v_max3_f32 v152, v152, v126, v127
  v_max_f32 v152, v152, v153
  v_mov_b32 v153, v152
  s_nop 1
  v_permlane32_swap_b32 v152, v153
  v_max_f32 v152, v152, v153
  v_max_f32 v152, 0, v152
  v_sub_f32 v153, 0, v152
  v_exp_f32 v153, v153
  v_add_f32 v162, v162, v152
  v_mul_f32 v163, v163, v153
  v_mul_f32 v32, v32, v153
  v_mul_f32 v33, v33, v153
  v_mul_f32 v34, v34, v153
  v_mul_f32 v35, v35, v153
  v_mul_f32 v36, v36, v153
  v_mul_f32 v37, v37, v153
  v_mul_f32 v38, v38, v153
  v_mul_f32 v39, v39, v153
  v_mul_f32 v40, v40, v153
  v_mul_f32 v41, v41, v153
  v_mul_f32 v42, v42, v153
  v_mul_f32 v43, v43, v153
  v_mul_f32 v44, v44, v153
  v_mul_f32 v45, v45, v153
  v_mul_f32 v46, v46, v153
  v_mul_f32 v47, v47, v153
  v_mul_f32 v48, v48, v153
  v_mul_f32 v49, v49, v153
  v_mul_f32 v50, v50, v153
  v_mul_f32 v51, v51, v153
  v_mul_f32 v52, v52, v153
  v_mul_f32 v53, v53, v153
  v_mul_f32 v54, v54, v153
  v_mul_f32 v55, v55, v153
  v_mul_f32 v56, v56, v153
  v_mul_f32 v57, v57, v153
  v_mul_f32 v58, v58, v153
  v_mul_f32 v59, v59, v153
  v_mul_f32 v60, v60, v153
  v_mul_f32 v61, v61, v153
  v_mul_f32 v62, v62, v153
  v_mul_f32 v63, v63, v153
  v_mul_f32 v64, v64, v153
  v_mul_f32 v65, v65, v153
  v_mul_f32 v66, v66, v153
  v_mul_f32 v67, v67, v153
  v_mul_f32 v68, v68, v153
  v_mul_f32 v69, v69, v153
  v_mul_f32 v70, v70, v153
  v_mul_f32 v71, v71, v153
  v_mul_f32 v72, v72, v153
  v_mul_f32 v73, v73, v153
  v_mul_f32 v74, v74, v153
  v_mul_f32 v75, v75, v153
  v_mul_f32 v76, v76, v153
  v_mul_f32 v77, v77, v153
  v_mul_f32 v78, v78, v153
  v_mul_f32 v79, v79, v153
  v_mul_f32 v80, v80, v153
  v_mul_f32 v81, v81, v153
  v_mul_f32 v82, v82, v153
  v_mul_f32 v83, v83, v153
  v_mul_f32 v84, v84, v153
  v_mul_f32 v85, v85, v153
  v_mul_f32 v86, v86, v153
  v_mul_f32 v87, v87, v153
  v_mul_f32 v88, v88, v153
  v_mul_f32 v89, v89, v153
  v_mul_f32 v90, v90, v153
  v_mul_f32 v91, v91, v153
  v_mul_f32 v92, v92, v153
  v_mul_f32 v93, v93, v153
  v_mul_f32 v94, v94, v153
  v_mul_f32 v95, v95, v153
  v_sub_f32 v112, v112, v152
  v_sub_f32 v113, v113, v152
  v_sub_f32 v114, v114, v152
  v_sub_f32 v115, v115, v152
  v_sub_f32 v116, v116, v152
  v_sub_f32 v117, v117, v152
  v_sub_f32 v118, v118, v152
  v_sub_f32 v119, v119, v152
  v_sub_f32 v120, v120, v152
  v_sub_f32 v121, v121, v152
  v_sub_f32 v122, v122, v152
  v_sub_f32 v123, v123, v152
  v_sub_f32 v124, v124, v152
  v_sub_f32 v125, v125, v152
  v_sub_f32 v126, v126, v152
  v_sub_f32 v127, v127, v152
  v_exp_f32 v152, v112
  v_exp_f32 v153, v113
  s_nop 0
  v_add_f32 v164, v152, v153
  v_cvt_pk_bf16_f32 v128, v152, v153
  v_exp_f32 v154, v114
  v_exp_f32 v155, v115
  v_add_f32 v164, v164, v154
  v_add_f32 v164, v164, v155
  v_cvt_pk_bf16_f32 v129, v154, v155
  v_exp_f32 v152, v116
  v_exp_f32 v153, v117
  v_add_f32 v164, v164, v152
  v_add_f32 v164, v164, v153
  v_cvt_pk_bf16_f32 v130, v152, v153
  v_exp_f32 v154, v118
  v_exp_f32 v155, v119
  v_add_f32 v164, v164, v154
  v_add_f32 v164, v164, v155
  v_cvt_pk_bf16_f32 v131, v154, v155
  v_exp_f32 v152, v120
  v_exp_f32 v153, v121
  s_nop 1
  s_branch L_backC1f
L_rareC2f:
  s_nop 15
  v_max3_f32 v152, v112, v113, v114
  v_max3_f32 v153, v115, v116, v117
  v_max3_f32 v152, v152, v118, v119
  v_max3_f32 v153, v153, v120, v121
  v_max3_f32 v152, v152, v122, v123
  v_max3_f32 v153, v153, v124, v125
  v_max3_f32 v152, v152, v126, v127
  v_max_f32 v152, v152, v153
  v_mov_b32 v153, v152
  s_nop 1
  v_permlane32_swap_b32 v152, v153
  v_max_f32 v152, v152, v153
  v_max_f32 v152, 0, v152
  v_sub_f32 v153, 0, v152
  v_exp_f32 v153, v153
  v_add_f32 v162, v162, v152
  v_mul_f32 v163, v163, v153
  v_mul_f32 v32, v32, v153
  v_mul_f32 v33, v33, v153
  v_mul_f32 v34, v34, v153
  v_mul_f32 v35, v35, v153
  v_mul_f32 v36, v36, v153
  v_mul_f32 v37, v37, v153
  v_mul_f32 v38, v38, v153
  v_mul_f32 v39, v39, v153
  v_mul_f32 v40, v40, v153
  v_mul_f32 v41, v41, v153
  v_mul_f32 v42, v42, v153
  v_mul_f32 v43, v43, v153
  v_mul_f32 v44, v44, v153
  v_mul_f32 v45, v45, v153
  v_mul_f32 v46, v46, v153
  v_mul_f32 v47, v47, v153
  v_mul_f32 v48, v48, v153
  v_mul_f32 v49, v49, v153
  v_mul_f32 v50, v50, v153
  v_mul_f32 v51, v51, v153
  v_mul_f32 v52, v52, v153
  v_mul_f32 v53, v53, v153
  v_mul_f32 v54, v54, v153
  v_mul_f32 v55, v55, v153
  v_mul_f32 v56, v56, v153
  v_mul_f32 v57, v57, v153
  v_mul_f32 v58, v58, v153
  v_mul_f32 v59, v59, v153
  v_mul_f32 v60, v60, v153
  v_mul_f32 v61, v61, v153
  v_mul_f32 v62, v62, v153
  v_mul_f32 v63, v63, v153
  v_mul_f32 v64, v64, v153
  v_mul_f32 v65, v65, v153
  v_mul_f32 v66, v66, v153
  v_mul_f32 v67, v67, v153
  v_mul_f32 v68, v68, v153
  v_mul_f32 v69, v69, v153
  v_mul_f32 v70, v70, v153
  v_mul_f32 v71, v71, v153
  v_mul_f32 v72, v72, v153
  v_mul_f32 v73, v73, v153
  v_mul_f32 v74, v74, v153
  v_mul_f32 v75, v75, v153
  v_mul_f32 v76, v76, v153
  v_mul_f32 v77, v77, v153
  v_mul_f32 v78, v78, v153
  v_mul_f32 v79, v79, v153
  v_mul_f32 v80, v80, v153
  v_mul_f32 v81, v81, v153
  v_mul_f32 v82, v82, v153
  v_mul_f32 v83, v83, v153
  v_mul_f32 v84, v84, v153
  v_mul_f32 v85, v85, v153
  v_mul_f32 v86, v86, v153
  v_mul_f32 v87, v87, v153
  v_mul_f32 v88, v88, v153
  v_mul_f32 v89, v89, v153
  v_mul_f32 v90, v90, v153
  v_mul_f32 v91, v91, v153
  v_mul_f32 v92, v92, v153
  v_mul_f32 v93, v93, v153
  v_mul_f32 v94, v94, v153
  v_mul_f32 v95, v95, v153
  v_sub_f32 v112, v112, v152
  v_sub_f32 v113, v113, v152
  v_sub_f32 v114, v114, v152
  v_sub_f32 v115, v115, v152
  v_sub_f32 v116, v116, v152
  v_sub_f32 v117, v117, v152
  v_sub_f32 v118, v118, v152
  v_sub_f32 v119, v119, v152
  v_sub_f32 v120, v120, v152
  v_sub_f32 v121, v121, v152
  v_sub_f32 v122, v122, v152
  v_sub_f32 v123, v123, v152
  v_sub_f32 v124, v124, v152
  v_sub_f32 v125, v125, v152
  v_sub_f32 v126, v126, v152
  v_sub_f32 v127, v127, v152
  v_exp_f32 v152, v112
  v_exp_f32 v153, v113
  s_nop 0
  v_add_f32 v164, v152, v153
  v_cvt_pk_bf16_f32 v128, v152, v153
  v_exp_f32 v154, v114
  v_exp_f32 v155, v115
  v_add_f32 v164, v164, v154
  v_add_f32 v164, v164, v155
  v_cvt_pk_bf16_f32 v129, v154, v155
  v_exp_f32 v152, v116
  v_exp_f32 v153, v117
  v_add_f32 v164, v164, v152
  v_add_f32 v164, v164, v153
  v_cvt_pk_bf16_f32 v130, v152, v153
  v_exp_f32 v154, v118
  v_exp_f32 v155, v119
  v_add_f32 v164, v164, v154
  v_add_f32 v164, v164, v155
  v_cvt_pk_bf16_f32 v131, v154, v155
  v_exp_f32 v152, v120
  v_exp_f32 v153, v121
  s_nop 0
  v_add_f32 v164, v152, v153
  v_cvt_pk_bf16_f32 v132, v152, v153
  v_exp_f32 v154, v122
  v_exp_f32 v155, v123
  v_add_f32 v164, v164, v154
  v_add_f32 v164, v164, v155
  v_cvt_pk_bf16_f32 v133, v154, v155
  v_exp_f32 v152, v124
  v_exp_f32 v153, v125
  v_add_f32 v164, v164, v152
  v_add_f32 v164, v164, v153
  v_cvt_pk_bf16_f32 v134, v152, v153
  v_exp_f32 v154, v126
  v_exp_f32 v155, v127
  v_add_f32 v164, v164, v154
  v_add_f32 v164, v164, v155
  v_cvt_pk_bf16_f32 v135, v154, v155
  s_nop 1
  s_branch L_backC2f
.section .rodata,"a"
.p2align 6
.amdhsa_kernel standalone__gqa_softmax__near_ridge_kernel
  .amdhsa_next_free_vgpr 168
  .amdhsa_next_free_sgpr 98
  .amdhsa_accum_offset 168
  .amdhsa_group_segment_fixed_size 0
  .amdhsa_kernarg_size 48
  .amdhsa_user_sgpr_count 2
  .amdhsa_user_sgpr_kernarg_segment_ptr 1
  .amdhsa_system_sgpr_workgroup_id_x 1
.end_amdhsa_kernel
```
